```python
import torch

def _softmax(x, axis=-1):
    return torch.softmax(x, dim=axis)
def _gelu(x):
    return torch.nn.functional.gelu(x, approximate="tanh")
def _silu(x):
    return torch.nn.functional.silu(x)
def _sigmoid(x):
    return torch.sigmoid(x)
def _layernorm(x, axis=-1, eps=1e-5):
    m = x.mean(dim=axis, keepdim=True)
    v = x.var(dim=axis, keepdim=True, unbiased=False)
    return (x - m) / torch.sqrt(v + eps)
def _scatter_add(tgt, idx, src, axis=0):
    return tgt.clone().index_add_(axis, idx, src)
def _segment_sum(src, seg, n):
    out = torch.zeros((n,) + src.shape[1:], dtype=src.dtype)
    return out.index_add_(0, seg, src)
def _pad(x, pw):
    flat = tuple(v for pair in reversed(pw) for v in pair)
    return torch.nn.functional.pad(x, flat)

kernel_name = 'sequential_preLN__sliding_block_cached__dense_activation_gelu__decode'

def setup_inputs():

    _w = (lambda a: (lambda t: t.to(torch.bfloat16) if t.is_floating_point() else t)(torch.as_tensor(a)))
    def _A_setup():
        B, Sq, D = 1, 1, 512
        Hq, Hkv, Sk, Dh = 32, 8, 65536, 128
        assert Hq % Hkv == 0, (Hq, Hkv)
        return {
            "x": _w((lambda *s: torch.randn(*s, dtype=torch.bfloat16) * 0.1)(B, Sq, D)),
            "k_cache": _w((lambda *s: torch.randn(*s, dtype=torch.bfloat16) * 1.6)(B, Hkv, Sk, Dh)),
            "v_cache": _w((lambda *s: torch.randn(*s, dtype=torch.bfloat16) * 1.6)(B, Hkv, Sk, Dh)),
            "wq": _w((lambda *s: torch.randn(*s, dtype=torch.bfloat16) * 1.6)(D, Hq * Dh) * (D ** -0.5)),
            "wo": _w((lambda *s: torch.randn(*s, dtype=torch.bfloat16) * 1.6)(Hq * Dh, D) * ((Hq * Dh) ** -0.5)),
        }
    _A_in = _A_setup()

    def _B_setup():
        B, S, D, F = 1, 1, 512, 1792
        return {
            "x": _w((lambda *s: torch.randn(*s, dtype=torch.bfloat16) * 0.1)(B, S, D)),
            "w1": _w((lambda *s: torch.randn(*s, dtype=torch.bfloat16) * 3.2)(D, F) * (D ** -0.5)),
            "b1": _w((lambda *s: torch.randn(*s, dtype=torch.bfloat16) * 3.2)(F) * 0.01),
            "w2": _w((lambda *s: torch.randn(*s, dtype=torch.bfloat16) * 3.2)(F, D) * (F ** -0.5)),
            "b2": _w((lambda *s: torch.randn(*s, dtype=torch.bfloat16) * 3.2)(D) * 0.01),
        }
    _B_in = _B_setup()

    return {
        "A_x": _A_in["x"],
        "A_k_cache": _A_in["k_cache"],
        "A_v_cache": _A_in["v_cache"],
        "A_wq": _A_in["wq"],
        "A_wo": _A_in["wo"],
        "B_x": _B_in["x"],
        "B_w1": _B_in["w1"],
        "B_b1": _B_in["b1"],
        "B_w2": _B_in["w2"],
        "B_b2": _B_in["b2"],
    }

def reference(A_x, A_k_cache, A_v_cache, A_wq, A_wo, B_x, B_w1, B_b1, B_w2, B_b2):
    def _A_ref(x, k_cache, v_cache, wq, wo):
        B, Sq, D = x.shape
        Hq, Dh = 32, 128
        Hkv, Sk = k_cache.shape[1], k_cache.shape[2]
        W = min(4096, max(256, Sk // 4))
        rep = Hq // Hkv
        q = (lambda x, *d: x.permute(*d))((x @ wq).reshape(B, Sq, Hq, Dh), 0, 2, 1, 3)
        k = (lambda x, n, axis: torch.repeat_interleave(x, n, dim=axis))(k_cache[:, :, Sk - W:, :], rep, axis=1)
        v = (lambda x, n, axis: torch.repeat_interleave(x, n, dim=axis))(v_cache[:, :, Sk - W:, :], rep, axis=1)
        scores = torch.einsum("bhqd,bhkd->bhqk", q, k) * (Dh ** -0.5)
        p = _softmax(scores, axis=-1)
        o = torch.einsum("bhqk,bhkd->bhqd", p, v)
        return (lambda x, *d: x.permute(*d))(o, 0, 2, 1, 3).reshape(B, Sq, Hq * Dh) @ wo

    def _B_ref(x, w1, b1, w2, b2):
        h = torch.einsum("bsd,df->bsf", x, w1) + b1
        h = _gelu(h)
        return torch.einsum("bsf,fd->bsd", h, w2) + b2

    x = A_x
    h = x + _A_ref(_layernorm(x, axis=-1), A_k_cache, A_v_cache, A_wq, A_wo)
    h2 = h + _B_ref(_layernorm(h, axis=-1), B_w1, B_b1, B_w2, B_b2)
    return h2
```

```asm
; @launch kernel=k1_qproj_kernel grid=(256,1,1) block=(256,1,1) lds=9216
; @launch kernel=k2_kernel grid=(256,1,1) block=(512,1,1) lds=36864
; @launch kernel=k3_wo_kernel grid=(256,1,1) block=(256,1,1) lds=8192
; @launch kernel=k4_kernel grid=(224,1,1) block=(512,1,1) lds=36864
; @launch kernel=k5_fin_kernel grid=(32,1,1) block=(256,1,1) lds=1024
.amdgcn_target "amdgcn-amd-amdhsa--gfx950"
.text
    .globl k2_kernel
    .p2align 8
    .type k2_kernel,@function
k2_kernel:
    s_cmp_ge_u32 s2, 256
    s_cbranch_scc1 K12_END
    s_load_dwordx4 s[44:47], s[0:1], 8
    s_load_dwordx2 s[60:61], s[0:1], 96
    v_and_b32 v1, 63, v0
    v_lshrrev_b32 v2, 6, v0
    s_and_b32 s28, s2, 7
    s_lshr_b32 s29, s2, 3
    s_lshl_b32 s30, s28, 5
    s_add_u32 s30, s30, s29
    v_readfirstlane_b32 s31, v2
    v_and_b32 v6, 15, v1
    v_lshrrev_b32 v7, 4, v1
    v_lshlrev_b32 v81, 11, v2
    s_lshl_b32 s24, s28, 24
    s_lshl_b32 s25, s29, 15
    s_add_u32 s24, s24, s25
    s_add_u32 s24, s24, 15728640
    v_and_b32 v3, 3, v1
    v_lshlrev_b32 v4, 8, v3
    v_lshl_add_u32 v4, v7, 4, v4
    s_lshl_b32 s25, s28, 10
    v_add_u32 v4, s25, v4
    v_lshl_add_u32 v5, v2, 4, v6
    v_lshlrev_b32 v5, 8, v5
    v_lshl_add_u32 v5, v7, 4, v5
    s_waitcnt lgkmcnt(0)
    s_mov_b32 s20, s60
    s_mov_b32 s21, s61
    s_mov_b32 s22, 1572864
    s_mov_b32 s23, 0x00020000
    s_add_u32 s12, s44, s24
    s_addc_u32 s13, s45, 0
    s_mov_b32 s14, 32768
    s_mov_b32 s15, 0x00020000
    s_add_u32 s16, s46, s24
    s_addc_u32 s17, s47, 0
    s_mov_b32 s18, 32768
    s_mov_b32 s19, 0x00020000
    buffer_load_dwordx4 v[8:11], v4, s[20:23], 0 offen offset:0
    buffer_load_dwordx4 v[12:15], v4, s[20:23], 0 offen offset:64
    buffer_load_dwordx4 v[16:19], v4, s[20:23], 0 offen offset:128
    buffer_load_dwordx4 v[20:23], v4, s[20:23], 0 offen offset:192
    buffer_load_dwordx4 v[32:35], v5, s[12:15], 0 offen offset:0
    buffer_load_dwordx4 v[36:39], v5, s[12:15], 0 offen offset:64
    buffer_load_dwordx4 v[40:43], v5, s[12:15], 0 offen offset:128
    buffer_load_dwordx4 v[44:47], v5, s[12:15], 0 offen offset:192
    v_lshlrev_b32 v5, 4, v2
    v_lshl_add_u32 v5, v7, 2, v5
    v_lshlrev_b32 v5, 8, v5
    v_lshl_add_u32 v5, v6, 4, v5
    buffer_load_dwordx4 v[48:51], v5, s[16:19], 0 offen offset:0
    buffer_load_dwordx4 v[52:55], v5, s[16:19], 0 offen offset:256
    buffer_load_dwordx4 v[56:59], v5, s[16:19], 0 offen offset:512
    buffer_load_dwordx4 v[60:63], v5, s[16:19], 0 offen offset:768
    s_waitcnt vmcnt(4)
    v_mfma_f32_16x16x32_bf16 v[24:27], v[32:35], v[8:11], 0
    v_mfma_f32_16x16x32_bf16 v[24:27], v[36:39], v[12:15], v[24:27]
    v_mfma_f32_16x16x32_bf16 v[24:27], v[40:43], v[16:19], v[24:27]
    v_mfma_f32_16x16x32_bf16 v[24:27], v[44:47], v[20:23], v[24:27]
    v_mov_b32 v28, 0x3db504f3
    s_nop 7
    v_cvt_pk_bf16_f32 v24, v24, v24
    v_lshlrev_b32 v24, 16, v24
    v_mul_f32 v24, v24, v28
    v_cvt_pk_bf16_f32 v24, v24, v24
    v_lshlrev_b32 v24, 16, v24
    v_cvt_pk_bf16_f32 v25, v25, v25
    v_lshlrev_b32 v25, 16, v25
    v_mul_f32 v25, v25, v28
    v_cvt_pk_bf16_f32 v25, v25, v25
    v_lshlrev_b32 v25, 16, v25
    v_cvt_pk_bf16_f32 v26, v26, v26
    v_lshlrev_b32 v26, 16, v26
    v_mul_f32 v26, v26, v28
    v_cvt_pk_bf16_f32 v26, v26, v26
    v_lshlrev_b32 v26, 16, v26
    v_cvt_pk_bf16_f32 v27, v27, v27
    v_lshlrev_b32 v27, 16, v27
    v_mul_f32 v27, v27, v28
    v_cvt_pk_bf16_f32 v27, v27, v27
    v_lshlrev_b32 v27, 16, v27
    v_max_f32 v30, v24, v25
    v_max3_f32 v30, v30, v26, v27
    v_mov_b32 v31, v30
    s_nop 1
    v_permlane16_swap_b32 v30, v31
    s_nop 1
    v_max_f32 v30, v30, v31
    v_mov_b32 v31, v30
    s_nop 1
    v_permlane32_swap_b32 v30, v31
    s_nop 1
    v_max_f32 v30, v30, v31
    v_sub_f32 v24, v24, v30
    v_mul_f32 v24, 0x3fb8aa3b, v24
    v_exp_f32 v24, v24
    v_sub_f32 v25, v25, v30
    v_mul_f32 v25, 0x3fb8aa3b, v25
    v_exp_f32 v25, v25
    v_sub_f32 v26, v26, v30
    v_mul_f32 v26, 0x3fb8aa3b, v26
    v_exp_f32 v26, v26
    v_sub_f32 v27, v27, v30
    v_mul_f32 v27, 0x3fb8aa3b, v27
    v_exp_f32 v27, v27
    s_nop 0
    v_add_f32 v31, v24, v25
    v_add_f32 v28, v26, v27
    v_add_f32 v31, v31, v28
    v_mov_b32 v28, v31
    s_nop 1
    v_permlane16_swap_b32 v31, v28
    s_nop 1
    v_add_f32 v31, v31, v28
    v_mov_b32 v28, v31
    s_nop 1
    v_permlane32_swap_b32 v31, v28
    s_nop 1
    v_add_f32 v31, v31, v28
    v_lshlrev_b32 v5, 5, v2
    v_lshl_add_u32 v5, v3, 3, v5
    ds_write_b64 v5, v[30:31] offset:18432
    v_mov_b32 v84, 0
    v_mov_b32 v85, 0
    v_mov_b32 v86, 0
    v_mov_b32 v87, 0
    v_mov_b32 v88, 0
    v_mov_b32 v89, 0
    v_mov_b32 v90, 0
    v_mov_b32 v91, 0
    v_mov_b32 v92, 0
    v_mov_b32 v93, 0
    v_mov_b32 v94, 0
    v_mov_b32 v95, 0
    v_mov_b32 v96, 0
    v_mov_b32 v97, 0
    v_mov_b32 v98, 0
    v_mov_b32 v99, 0
    v_mov_b32 v100, 0
    v_mov_b32 v101, 0
    v_mov_b32 v102, 0
    v_mov_b32 v103, 0
    v_mov_b32 v104, 0
    v_mov_b32 v105, 0
    v_mov_b32 v106, 0
    v_mov_b32 v107, 0
    v_mov_b32 v108, 0
    v_mov_b32 v109, 0
    v_mov_b32 v110, 0
    v_mov_b32 v111, 0
    v_mov_b32 v112, 0
    v_mov_b32 v113, 0
    v_mov_b32 v114, 0
    v_mov_b32 v115, 0
    s_waitcnt vmcnt(3)
    v_lshlrev_b32 v8, 16, v48
    v_and_b32 v9, 0xffff0000, v48
    v_lshlrev_b32 v10, 16, v49
    v_and_b32 v11, 0xffff0000, v49
    v_lshlrev_b32 v12, 16, v50
    v_and_b32 v13, 0xffff0000, v50
    v_lshlrev_b32 v14, 16, v51
    v_and_b32 v15, 0xffff0000, v51
    v_mov_b32_dpp v16, v24 quad_perm:[0,0,0,0] row_mask:0xf bank_mask:0xf
    v_mov_b32_dpp v18, v24 quad_perm:[1,1,1,1] row_mask:0xf bank_mask:0xf
    v_mov_b32_dpp v20, v24 quad_perm:[2,2,2,2] row_mask:0xf bank_mask:0xf
    v_mov_b32_dpp v22, v24 quad_perm:[3,3,3,3] row_mask:0xf bank_mask:0xf
    v_pk_fma_f32 v[84:85], v[8:9], v[16:17], v[84:85] op_sel_hi:[1,0,1]
    v_pk_fma_f32 v[86:87], v[10:11], v[16:17], v[86:87] op_sel_hi:[1,0,1]
    v_pk_fma_f32 v[88:89], v[12:13], v[16:17], v[88:89] op_sel_hi:[1,0,1]
    v_pk_fma_f32 v[90:91], v[14:15], v[16:17], v[90:91] op_sel_hi:[1,0,1]
    v_pk_fma_f32 v[92:93], v[8:9], v[18:19], v[92:93] op_sel_hi:[1,0,1]
    v_pk_fma_f32 v[94:95], v[10:11], v[18:19], v[94:95] op_sel_hi:[1,0,1]
    v_pk_fma_f32 v[96:97], v[12:13], v[18:19], v[96:97] op_sel_hi:[1,0,1]
    v_pk_fma_f32 v[98:99], v[14:15], v[18:19], v[98:99] op_sel_hi:[1,0,1]
    v_pk_fma_f32 v[100:101], v[8:9], v[20:21], v[100:101] op_sel_hi:[1,0,1]
    v_pk_fma_f32 v[102:103], v[10:11], v[20:21], v[102:103] op_sel_hi:[1,0,1]
    v_pk_fma_f32 v[104:105], v[12:13], v[20:21], v[104:105] op_sel_hi:[1,0,1]
    v_pk_fma_f32 v[106:107], v[14:15], v[20:21], v[106:107] op_sel_hi:[1,0,1]
    v_pk_fma_f32 v[108:109], v[8:9], v[22:23], v[108:109] op_sel_hi:[1,0,1]
    v_pk_fma_f32 v[110:111], v[10:11], v[22:23], v[110:111] op_sel_hi:[1,0,1]
    v_pk_fma_f32 v[112:113], v[12:13], v[22:23], v[112:113] op_sel_hi:[1,0,1]
    v_pk_fma_f32 v[114:115], v[14:15], v[22:23], v[114:115] op_sel_hi:[1,0,1]
    s_waitcnt vmcnt(2)
    v_lshlrev_b32 v8, 16, v52
    v_and_b32 v9, 0xffff0000, v52
    v_lshlrev_b32 v10, 16, v53
    v_and_b32 v11, 0xffff0000, v53
    v_lshlrev_b32 v12, 16, v54
    v_and_b32 v13, 0xffff0000, v54
    v_lshlrev_b32 v14, 16, v55
    v_and_b32 v15, 0xffff0000, v55
    v_mov_b32_dpp v16, v25 quad_perm:[0,0,0,0] row_mask:0xf bank_mask:0xf
    v_mov_b32_dpp v18, v25 quad_perm:[1,1,1,1] row_mask:0xf bank_mask:0xf
    v_mov_b32_dpp v20, v25 quad_perm:[2,2,2,2] row_mask:0xf bank_mask:0xf
    v_mov_b32_dpp v22, v25 quad_perm:[3,3,3,3] row_mask:0xf bank_mask:0xf
    v_pk_fma_f32 v[84:85], v[8:9], v[16:17], v[84:85] op_sel_hi:[1,0,1]
    v_pk_fma_f32 v[86:87], v[10:11], v[16:17], v[86:87] op_sel_hi:[1,0,1]
    v_pk_fma_f32 v[88:89], v[12:13], v[16:17], v[88:89] op_sel_hi:[1,0,1]
    v_pk_fma_f32 v[90:91], v[14:15], v[16:17], v[90:91] op_sel_hi:[1,0,1]
    v_pk_fma_f32 v[92:93], v[8:9], v[18:19], v[92:93] op_sel_hi:[1,0,1]
    v_pk_fma_f32 v[94:95], v[10:11], v[18:19], v[94:95] op_sel_hi:[1,0,1]
    v_pk_fma_f32 v[96:97], v[12:13], v[18:19], v[96:97] op_sel_hi:[1,0,1]
    v_pk_fma_f32 v[98:99], v[14:15], v[18:19], v[98:99] op_sel_hi:[1,0,1]
    v_pk_fma_f32 v[100:101], v[8:9], v[20:21], v[100:101] op_sel_hi:[1,0,1]
    v_pk_fma_f32 v[102:103], v[10:11], v[20:21], v[102:103] op_sel_hi:[1,0,1]
    v_pk_fma_f32 v[104:105], v[12:13], v[20:21], v[104:105] op_sel_hi:[1,0,1]
    v_pk_fma_f32 v[106:107], v[14:15], v[20:21], v[106:107] op_sel_hi:[1,0,1]
    v_pk_fma_f32 v[108:109], v[8:9], v[22:23], v[108:109] op_sel_hi:[1,0,1]
    v_pk_fma_f32 v[110:111], v[10:11], v[22:23], v[110:111] op_sel_hi:[1,0,1]
    v_pk_fma_f32 v[112:113], v[12:13], v[22:23], v[112:113] op_sel_hi:[1,0,1]
    v_pk_fma_f32 v[114:115], v[14:15], v[22:23], v[114:115] op_sel_hi:[1,0,1]
    s_waitcnt vmcnt(1)
    v_lshlrev_b32 v8, 16, v56
    v_and_b32 v9, 0xffff0000, v56
    v_lshlrev_b32 v10, 16, v57
    v_and_b32 v11, 0xffff0000, v57
    v_lshlrev_b32 v12, 16, v58
    v_and_b32 v13, 0xffff0000, v58
    v_lshlrev_b32 v14, 16, v59
    v_and_b32 v15, 0xffff0000, v59
    v_mov_b32_dpp v16, v26 quad_perm:[0,0,0,0] row_mask:0xf bank_mask:0xf
    v_mov_b32_dpp v18, v26 quad_perm:[1,1,1,1] row_mask:0xf bank_mask:0xf
    v_mov_b32_dpp v20, v26 quad_perm:[2,2,2,2] row_mask:0xf bank_mask:0xf
    v_mov_b32_dpp v22, v26 quad_perm:[3,3,3,3] row_mask:0xf bank_mask:0xf
    v_pk_fma_f32 v[84:85], v[8:9], v[16:17], v[84:85] op_sel_hi:[1,0,1]
    v_pk_fma_f32 v[86:87], v[10:11], v[16:17], v[86:87] op_sel_hi:[1,0,1]
    v_pk_fma_f32 v[88:89], v[12:13], v[16:17], v[88:89] op_sel_hi:[1,0,1]
    v_pk_fma_f32 v[90:91], v[14:15], v[16:17], v[90:91] op_sel_hi:[1,0,1]
    v_pk_fma_f32 v[92:93], v[8:9], v[18:19], v[92:93] op_sel_hi:[1,0,1]
    v_pk_fma_f32 v[94:95], v[10:11], v[18:19], v[94:95] op_sel_hi:[1,0,1]
    v_pk_fma_f32 v[96:97], v[12:13], v[18:19], v[96:97] op_sel_hi:[1,0,1]
    v_pk_fma_f32 v[98:99], v[14:15], v[18:19], v[98:99] op_sel_hi:[1,0,1]
    v_pk_fma_f32 v[100:101], v[8:9], v[20:21], v[100:101] op_sel_hi:[1,0,1]
    v_pk_fma_f32 v[102:103], v[10:11], v[20:21], v[102:103] op_sel_hi:[1,0,1]
    v_pk_fma_f32 v[104:105], v[12:13], v[20:21], v[104:105] op_sel_hi:[1,0,1]
    v_pk_fma_f32 v[106:107], v[14:15], v[20:21], v[106:107] op_sel_hi:[1,0,1]
    v_pk_fma_f32 v[108:109], v[8:9], v[22:23], v[108:109] op_sel_hi:[1,0,1]
    v_pk_fma_f32 v[110:111], v[10:11], v[22:23], v[110:111] op_sel_hi:[1,0,1]
    v_pk_fma_f32 v[112:113], v[12:13], v[22:23], v[112:113] op_sel_hi:[1,0,1]
    v_pk_fma_f32 v[114:115], v[14:15], v[22:23], v[114:115] op_sel_hi:[1,0,1]
    s_waitcnt vmcnt(0)
    v_lshlrev_b32 v8, 16, v60
    v_and_b32 v9, 0xffff0000, v60
    v_lshlrev_b32 v10, 16, v61
    v_and_b32 v11, 0xffff0000, v61
    v_lshlrev_b32 v12, 16, v62
    v_and_b32 v13, 0xffff0000, v62
    v_lshlrev_b32 v14, 16, v63
    v_and_b32 v15, 0xffff0000, v63
    v_mov_b32_dpp v16, v27 quad_perm:[0,0,0,0] row_mask:0xf bank_mask:0xf
    v_mov_b32_dpp v18, v27 quad_perm:[1,1,1,1] row_mask:0xf bank_mask:0xf
    v_mov_b32_dpp v20, v27 quad_perm:[2,2,2,2] row_mask:0xf bank_mask:0xf
    v_mov_b32_dpp v22, v27 quad_perm:[3,3,3,3] row_mask:0xf bank_mask:0xf
    v_pk_fma_f32 v[84:85], v[8:9], v[16:17], v[84:85] op_sel_hi:[1,0,1]
    v_pk_fma_f32 v[86:87], v[10:11], v[16:17], v[86:87] op_sel_hi:[1,0,1]
    v_pk_fma_f32 v[88:89], v[12:13], v[16:17], v[88:89] op_sel_hi:[1,0,1]
    v_pk_fma_f32 v[90:91], v[14:15], v[16:17], v[90:91] op_sel_hi:[1,0,1]
    v_pk_fma_f32 v[92:93], v[8:9], v[18:19], v[92:93] op_sel_hi:[1,0,1]
    v_pk_fma_f32 v[94:95], v[10:11], v[18:19], v[94:95] op_sel_hi:[1,0,1]
    v_pk_fma_f32 v[96:97], v[12:13], v[18:19], v[96:97] op_sel_hi:[1,0,1]
    v_pk_fma_f32 v[98:99], v[14:15], v[18:19], v[98:99] op_sel_hi:[1,0,1]
    v_pk_fma_f32 v[100:101], v[8:9], v[20:21], v[100:101] op_sel_hi:[1,0,1]
    v_pk_fma_f32 v[102:103], v[10:11], v[20:21], v[102:103] op_sel_hi:[1,0,1]
    v_pk_fma_f32 v[104:105], v[12:13], v[20:21], v[104:105] op_sel_hi:[1,0,1]
    v_pk_fma_f32 v[106:107], v[14:15], v[20:21], v[106:107] op_sel_hi:[1,0,1]
    v_pk_fma_f32 v[108:109], v[8:9], v[22:23], v[108:109] op_sel_hi:[1,0,1]
    v_pk_fma_f32 v[110:111], v[10:11], v[22:23], v[110:111] op_sel_hi:[1,0,1]
    v_pk_fma_f32 v[112:113], v[12:13], v[22:23], v[112:113] op_sel_hi:[1,0,1]
    v_pk_fma_f32 v[114:115], v[14:15], v[22:23], v[114:115] op_sel_hi:[1,0,1]
    s_nop 1
    v_permlane32_swap_b32 v84, v100
    v_permlane32_swap_b32 v85, v101
    v_permlane32_swap_b32 v86, v102
    v_permlane32_swap_b32 v87, v103
    v_permlane32_swap_b32 v88, v104
    v_permlane32_swap_b32 v89, v105
    v_permlane32_swap_b32 v90, v106
    v_permlane32_swap_b32 v91, v107
    v_permlane32_swap_b32 v92, v108
    v_permlane32_swap_b32 v93, v109
    v_permlane32_swap_b32 v94, v110
    v_permlane32_swap_b32 v95, v111
    v_permlane32_swap_b32 v96, v112
    v_permlane32_swap_b32 v97, v113
    v_permlane32_swap_b32 v98, v114
    v_permlane32_swap_b32 v99, v115
    s_nop 1
    v_add_f32 v84, v84, v100
    v_add_f32 v85, v85, v101
    v_add_f32 v86, v86, v102
    v_add_f32 v87, v87, v103
    v_add_f32 v88, v88, v104
    v_add_f32 v89, v89, v105
    v_add_f32 v90, v90, v106
    v_add_f32 v91, v91, v107
    v_add_f32 v92, v92, v108
    v_add_f32 v93, v93, v109
    v_add_f32 v94, v94, v110
    v_add_f32 v95, v95, v111
    v_add_f32 v96, v96, v112
    v_add_f32 v97, v97, v113
    v_add_f32 v98, v98, v114
    v_add_f32 v99, v99, v115
    s_nop 1
    v_permlane16_swap_b32 v84, v92
    v_permlane16_swap_b32 v85, v93
    v_permlane16_swap_b32 v86, v94
    v_permlane16_swap_b32 v87, v95
    v_permlane16_swap_b32 v88, v96
    v_permlane16_swap_b32 v89, v97
    v_permlane16_swap_b32 v90, v98
    v_permlane16_swap_b32 v91, v99
    s_nop 1
    v_add_f32 v84, v84, v92
    v_add_f32 v85, v85, v93
    v_add_f32 v86, v86, v94
    v_add_f32 v87, v87, v95
    v_add_f32 v88, v88, v96
    v_add_f32 v89, v89, v97
    v_add_f32 v90, v90, v98
    v_add_f32 v91, v91, v99
    v_lshl_add_u32 v5, v1, 5, v81
    ds_write_b128 v5, v[84:87] offset:20480
    ds_write_b128 v5, v[88:91] offset:20496
    s_waitcnt lgkmcnt(0)
    s_barrier
    v_lshrrev_b32 v3, 7, v0
    v_lshlrev_b32 v5, 3, v3
    ds_read_b64 v[8:9], v5 offset:18432
    ds_read_b64 v[10:11], v5 offset:18464
    ds_read_b64 v[12:13], v5 offset:18496
    ds_read_b64 v[14:15], v5 offset:18528
    ds_read_b64 v[16:17], v5 offset:18560
    ds_read_b64 v[18:19], v5 offset:18592
    ds_read_b64 v[20:21], v5 offset:18624
    ds_read_b64 v[22:23], v5 offset:18656
    v_lshlrev_b32 v5, 2, v0
    ds_read_b32 v24, v5 offset:20480
    ds_read_b32 v25, v5 offset:22528
    ds_read_b32 v26, v5 offset:24576
    ds_read_b32 v27, v5 offset:26624
    ds_read_b32 v28, v5 offset:28672
    ds_read_b32 v29, v5 offset:30720
    ds_read_b32 v30, v5 offset:32768
    ds_read_b32 v31, v5 offset:34816
    s_waitcnt lgkmcnt(8)
    v_max3_f32 v32, v8, v10, v12
    v_max3_f32 v33, v14, v16, v18
    v_max3_f32 v32, v32, v20, v22
    v_max_f32 v32, v32, v33
    v_sub_f32 v8, v8, v32
    v_mul_f32 v8, 0x3fb8aa3b, v8
    v_exp_f32 v8, v8
    v_sub_f32 v10, v10, v32
    v_mul_f32 v10, 0x3fb8aa3b, v10
    v_exp_f32 v10, v10
    v_sub_f32 v12, v12, v32
    v_mul_f32 v12, 0x3fb8aa3b, v12
    v_exp_f32 v12, v12
    v_sub_f32 v14, v14, v32
    v_mul_f32 v14, 0x3fb8aa3b, v14
    v_exp_f32 v14, v14
    v_sub_f32 v16, v16, v32
    v_mul_f32 v16, 0x3fb8aa3b, v16
    v_exp_f32 v16, v16
    v_sub_f32 v18, v18, v32
    v_mul_f32 v18, 0x3fb8aa3b, v18
    v_exp_f32 v18, v18
    v_sub_f32 v20, v20, v32
    v_mul_f32 v20, 0x3fb8aa3b, v20
    v_exp_f32 v20, v20
    v_sub_f32 v22, v22, v32
    v_mul_f32 v22, 0x3fb8aa3b, v22
    v_exp_f32 v22, v22
    s_waitcnt lgkmcnt(0)
    v_mul_f32 v34, v8, v24
    v_mul_f32 v33, v8, v9
    v_fmac_f32 v34, v10, v25
    v_fmac_f32 v33, v10, v11
    v_fmac_f32 v34, v12, v26
    v_fmac_f32 v33, v12, v13
    v_fmac_f32 v34, v14, v27
    v_fmac_f32 v33, v14, v15
    v_fmac_f32 v34, v16, v28
    v_fmac_f32 v33, v16, v17
    v_fmac_f32 v34, v18, v29
    v_fmac_f32 v33, v18, v19
    v_fmac_f32 v34, v20, v30
    v_fmac_f32 v33, v20, v21
    v_fmac_f32 v34, v22, v31
    v_fmac_f32 v33, v22, v23
    s_lshl_b32 s24, s30, 11
    s_add_u32 s24, s24, 65536
    v_add_u32 v5, s24, v5
    buffer_store_dword v34, v5, s[20:23], 0 offen
    v_and_b32 v4, 127, v0
    v_cmp_eq_u32 vcc, 0, v4
    s_and_saveexec_b64 s[24:25], vcc
    s_lshl_b32 s26, s30, 5
    s_add_u32 s26, s26, 589824
    v_lshlrev_b32 v5, 3, v3
    v_add_u32 v5, s26, v5
    buffer_store_dwordx2 v[32:33], v5, s[20:23], 0 offen
    s_mov_b64 exec, s[24:25]
    s_endpgm
K12_END:
    s_endpgm
    .globl k4_kernel
    .p2align 8
    .type k4_kernel,@function
k4_kernel:
    s_cmp_ge_u32 s2, 224
    s_cbranch_scc1 K4_END
    s_load_dwordx2 s[60:61], s[0:1], 96
    s_load_dwordx2 s[44:45], s[0:1], 0
    s_load_dwordx4 s[56:59], s[0:1], 48
    s_load_dwordx2 s[32:33], s[0:1], 64
    v_and_b32 v1, 63, v0
    v_lshrrev_b32 v2, 6, v0
    v_and_b32 v6, 15, v1
    v_lshrrev_b32 v7, 4, v1
    v_lshlrev_b32 v81, 11, v2
    v_readfirstlane_b32 s31, v2
    s_and_b32 s24, s2, 7
    s_mul_i32 s24, s24, 7
    s_lshr_b32 s25, s2, 5
    s_add_u32 s24, s24, s25
    s_lshl_b32 s24, s24, 5
    s_lshr_b32 s25, s2, 3
    s_and_b32 s25, s25, 3
    s_lshl_b32 s25, s25, 3
    s_add_u32 s62, s24, s25
    v_and_b32 v3, 127, v0
    v_lshrrev_b32 v4, 7, v0
    v_lshlrev_b32 v5, 14, v4
    v_lshl_add_u32 v5, v3, 4, v5
    v_add_u32 v5, 655360, v5
    s_waitcnt lgkmcnt(0)
    s_mov_b32 s20, s60
    s_mov_b32 s21, s61
    s_mov_b32 s22, 1572864
    s_mov_b32 s23, 0x00020000
    buffer_load_dwordx4 v[8:11], v5, s[20:23], 0 offen offset:0
    buffer_load_dwordx4 v[12:15], v5, s[20:23], 0 offen offset:2048
    v_add_u32 v5, 0x1000, v5
    buffer_load_dwordx4 v[16:19], v5, s[20:23], 0 offen offset:0
    buffer_load_dwordx4 v[20:23], v5, s[20:23], 0 offen offset:2048
    v_add_u32 v5, 0x1000, v5
    buffer_load_dwordx4 v[24:27], v5, s[20:23], 0 offen offset:0
    buffer_load_dwordx4 v[28:31], v5, s[20:23], 0 offen offset:2048
    v_add_u32 v5, 0x1000, v5
    buffer_load_dwordx4 v[32:35], v5, s[20:23], 0 offen offset:0
    buffer_load_dwordx4 v[36:39], v5, s[20:23], 0 offen offset:2048
    s_mov_b32 s4, s44
    s_mov_b32 s5, s45
    s_mov_b32 s6, 1024
    s_mov_b32 s7, 0x00020000
    v_lshlrev_b32 v5, 4, v1
    buffer_load_dwordx4 v[40:43], v5, s[4:7], 0 offen
    s_mov_b32 s8, s56
    s_mov_b32 s9, s57
    s_mov_b32 s10, 1835008
    s_mov_b32 s11, 0x00020000
    s_lshl_b32 s24, s62, 1
    s_movk_i32 s25, 3584
    v_mul_lo_u32 v5, v0, s25
    v_add_u32 v5, s24, v5
    buffer_load_dwordx4 v[72:75], v5, s[8:11], 0 offen
    s_mov_b32 s16, s58
    s_mov_b32 s17, s59
    s_mov_b32 s18, 3584
    s_mov_b32 s19, 0x00020000
    v_and_b32 v5, 7, v0
    v_lshlrev_b32 v5, 1, v5
    v_add_u32 v5, s24, v5
    buffer_load_ushort v80, v5, s[16:19], 0 offen
    s_mov_b32 s12, s32
    s_mov_b32 s13, s33
    s_mov_b32 s14, 1835008
    s_mov_b32 s15, 0x00020000
    s_lshl_b32 s25, s62, 10
    v_lshlrev_b32 v5, 10, v2
    v_lshl_add_u32 v5, v1, 4, v5
    v_add_u32 v5, s25, v5
    buffer_load_dwordx4 v[76:79], v5, s[12:15], 0 offen
    s_waitcnt vmcnt(4)
    v_add_f32 v8, v8, v12
    v_add_f32 v9, v9, v13
    v_add_f32 v10, v10, v14
    v_add_f32 v11, v11, v15
    v_add_f32 v8, v8, v16
    v_add_f32 v9, v9, v17
    v_add_f32 v10, v10, v18
    v_add_f32 v11, v11, v19
    v_add_f32 v8, v8, v20
    v_add_f32 v9, v9, v21
    v_add_f32 v10, v10, v22
    v_add_f32 v11, v11, v23
    v_add_f32 v8, v8, v24
    v_add_f32 v9, v9, v25
    v_add_f32 v10, v10, v26
    v_add_f32 v11, v11, v27
    v_add_f32 v8, v8, v28
    v_add_f32 v9, v9, v29
    v_add_f32 v10, v10, v30
    v_add_f32 v11, v11, v31
    v_add_f32 v8, v8, v32
    v_add_f32 v9, v9, v33
    v_add_f32 v10, v10, v34
    v_add_f32 v11, v11, v35
    v_add_f32 v8, v8, v36
    v_add_f32 v9, v9, v37
    v_add_f32 v10, v10, v38
    v_add_f32 v11, v11, v39
    v_lshlrev_b32 v5, 4, v0
    ds_write_b128 v5, v[8:11] offset:20480
    s_waitcnt lgkmcnt(0)
    s_barrier
    v_lshlrev_b32 v5, 5, v1
    ds_read_b128 v[8:11], v5 offset:20480
    ds_read_b128 v[12:15], v5 offset:20496
    ds_read_b128 v[16:19], v5 offset:22528
    ds_read_b128 v[20:23], v5 offset:22544
    ds_read_b128 v[24:27], v5 offset:24576
    ds_read_b128 v[28:31], v5 offset:24592
    ds_read_b128 v[32:35], v5 offset:26624
    ds_read_b128 v[36:39], v5 offset:26640
    s_waitcnt lgkmcnt(0) vmcnt(3)
    v_lshlrev_b32 v44, 16, v40
    v_and_b32 v45, 0xffff0000, v40
    v_lshlrev_b32 v46, 16, v41
    v_and_b32 v47, 0xffff0000, v41
    v_lshlrev_b32 v48, 16, v42
    v_and_b32 v49, 0xffff0000, v42
    v_lshlrev_b32 v50, 16, v43
    v_and_b32 v51, 0xffff0000, v43
    v_add_f32 v8, v8, v16
    v_add_f32 v24, v24, v32
    v_add_f32 v8, v8, v24
    v_cvt_pk_bf16_f32 v8, v8, v8
    v_lshlrev_b32 v8, 16, v8
    v_add_f32 v8, v8, v44
    v_cvt_pk_bf16_f32 v8, v8, v8
    v_lshlrev_b32 v8, 16, v8
    v_mov_b32 v84, v8
    v_add_f32 v9, v9, v17
    v_add_f32 v25, v25, v33
    v_add_f32 v9, v9, v25
    v_cvt_pk_bf16_f32 v9, v9, v9
    v_lshlrev_b32 v9, 16, v9
    v_add_f32 v9, v9, v45
    v_cvt_pk_bf16_f32 v9, v9, v9
    v_lshlrev_b32 v9, 16, v9
    v_mov_b32 v85, v9
    v_add_f32 v10, v10, v18
    v_add_f32 v26, v26, v34
    v_add_f32 v10, v10, v26
    v_cvt_pk_bf16_f32 v10, v10, v10
    v_lshlrev_b32 v10, 16, v10
    v_add_f32 v10, v10, v46
    v_cvt_pk_bf16_f32 v10, v10, v10
    v_lshlrev_b32 v10, 16, v10
    v_mov_b32 v86, v10
    v_add_f32 v11, v11, v19
    v_add_f32 v27, v27, v35
    v_add_f32 v11, v11, v27
    v_cvt_pk_bf16_f32 v11, v11, v11
    v_lshlrev_b32 v11, 16, v11
    v_add_f32 v11, v11, v47
    v_cvt_pk_bf16_f32 v11, v11, v11
    v_lshlrev_b32 v11, 16, v11
    v_mov_b32 v87, v11
    v_add_f32 v12, v12, v20
    v_add_f32 v28, v28, v36
    v_add_f32 v12, v12, v28
    v_cvt_pk_bf16_f32 v12, v12, v12
    v_lshlrev_b32 v12, 16, v12
    v_add_f32 v12, v12, v48
    v_cvt_pk_bf16_f32 v12, v12, v12
    v_lshlrev_b32 v12, 16, v12
    v_mov_b32 v88, v12
    v_add_f32 v13, v13, v21
    v_add_f32 v29, v29, v37
    v_add_f32 v13, v13, v29
    v_cvt_pk_bf16_f32 v13, v13, v13
    v_lshlrev_b32 v13, 16, v13
    v_add_f32 v13, v13, v49
    v_cvt_pk_bf16_f32 v13, v13, v13
    v_lshlrev_b32 v13, 16, v13
    v_mov_b32 v89, v13
    v_add_f32 v14, v14, v22
    v_add_f32 v30, v30, v38
    v_add_f32 v14, v14, v30
    v_cvt_pk_bf16_f32 v14, v14, v14
    v_lshlrev_b32 v14, 16, v14
    v_add_f32 v14, v14, v50
    v_cvt_pk_bf16_f32 v14, v14, v14
    v_lshlrev_b32 v14, 16, v14
    v_mov_b32 v90, v14
    v_add_f32 v15, v15, v23
    v_add_f32 v31, v31, v39
    v_add_f32 v15, v15, v31
    v_cvt_pk_bf16_f32 v15, v15, v15
    v_lshlrev_b32 v15, 16, v15
    v_add_f32 v15, v15, v51
    v_cvt_pk_bf16_f32 v15, v15, v15
    v_lshlrev_b32 v15, 16, v15
    v_mov_b32 v91, v15
    s_or_b32 s24, s2, s31
    s_cmp_lg_u32 s24, 0
    s_cbranch_scc1 K4_NOH
    v_lshlrev_b32 v5, 5, v1
    v_add_u32 v5, 1310720, v5
    buffer_store_dwordx4 v[84:87], v5, s[20:23], 0 offen
    buffer_store_dwordx4 v[88:91], v5, s[20:23], 0 offen offset:16
K4_NOH:
    v_add_f32 v16, v8, v9
    v_add_f32 v16, v16, v10
    v_add_f32 v16, v16, v11
    v_add_f32 v16, v16, v12
    v_add_f32 v16, v16, v13
    v_add_f32 v16, v16, v14
    v_add_f32 v16, v16, v15
    s_nop 1
    v_add_f32_dpp v16, v16, v16 row_shr:1 row_mask:0xf bank_mask:0xf bound_ctrl:0
    s_nop 1
    v_add_f32_dpp v16, v16, v16 row_shr:2 row_mask:0xf bank_mask:0xf bound_ctrl:0
    s_nop 1
    v_add_f32_dpp v16, v16, v16 row_shr:4 row_mask:0xf bank_mask:0xf bound_ctrl:0
    s_nop 1
    v_add_f32_dpp v16, v16, v16 row_shr:8 row_mask:0xf bank_mask:0xf bound_ctrl:0
    s_nop 1
    v_add_f32_dpp v16, v16, v16 row_bcast:15 row_mask:0xa bank_mask:0xf
    s_nop 1
    v_add_f32_dpp v16, v16, v16 row_bcast:31 row_mask:0xc bank_mask:0xf
    s_nop 1
    v_readlane_b32 s24, v16, 63
    s_nop 1
    v_mov_b32 v16, s24
    v_mul_f32 v16, 0x3b000000, v16
    v_sub_f32 v17, v8, v16
    v_mul_f32 v18, v17, v17
    v_sub_f32 v17, v9, v16
    v_fmac_f32 v18, v17, v17
    v_sub_f32 v17, v10, v16
    v_fmac_f32 v18, v17, v17
    v_sub_f32 v17, v11, v16
    v_fmac_f32 v18, v17, v17
    v_sub_f32 v17, v12, v16
    v_fmac_f32 v18, v17, v17
    v_sub_f32 v17, v13, v16
    v_fmac_f32 v18, v17, v17
    v_sub_f32 v17, v14, v16
    v_fmac_f32 v18, v17, v17
    v_sub_f32 v17, v15, v16
    v_fmac_f32 v18, v17, v17
    s_nop 1
    v_add_f32_dpp v18, v18, v18 row_shr:1 row_mask:0xf bank_mask:0xf bound_ctrl:0
    s_nop 1
    v_add_f32_dpp v18, v18, v18 row_shr:2 row_mask:0xf bank_mask:0xf bound_ctrl:0
    s_nop 1
    v_add_f32_dpp v18, v18, v18 row_shr:4 row_mask:0xf bank_mask:0xf bound_ctrl:0
    s_nop 1
    v_add_f32_dpp v18, v18, v18 row_shr:8 row_mask:0xf bank_mask:0xf bound_ctrl:0
    s_nop 1
    v_add_f32_dpp v18, v18, v18 row_bcast:15 row_mask:0xa bank_mask:0xf
    s_nop 1
    v_add_f32_dpp v18, v18, v18 row_bcast:31 row_mask:0xc bank_mask:0xf
    s_nop 1
    v_readlane_b32 s25, v18, 63
    s_nop 1
    v_mov_b32 v18, s25
    v_mul_f32 v18, 0x3b000000, v18
    v_cvt_pk_bf16_f32 v18, v18, v18
    v_lshlrev_b32 v18, 16, v18
    v_add_f32 v18, 0x3727c5ac, v18
    v_cvt_pk_bf16_f32 v18, v18, v18
    v_lshlrev_b32 v18, 16, v18
    v_sqrt_f32 v18, v18
    s_nop 0
    v_cvt_pk_bf16_f32 v18, v18, v18
    v_lshlrev_b32 v18, 16, v18
    v_rcp_f32 v18, v18
    v_cvt_pk_bf16_f32 v16, v16, v16
    v_lshlrev_b32 v16, 16, v16
    v_sub_f32 v8, v8, v16
    v_cvt_pk_bf16_f32 v8, v8, v8
    v_lshlrev_b32 v8, 16, v8
    v_mul_f32 v8, v8, v18
    v_cvt_pk_bf16_f32 v8, v8, v8
    v_lshlrev_b32 v8, 16, v8
    v_sub_f32 v9, v9, v16
    v_cvt_pk_bf16_f32 v9, v9, v9
    v_lshlrev_b32 v9, 16, v9
    v_mul_f32 v9, v9, v18
    v_cvt_pk_bf16_f32 v9, v9, v9
    v_lshlrev_b32 v9, 16, v9
    v_sub_f32 v10, v10, v16
    v_cvt_pk_bf16_f32 v10, v10, v10
    v_lshlrev_b32 v10, 16, v10
    v_mul_f32 v10, v10, v18
    v_cvt_pk_bf16_f32 v10, v10, v10
    v_lshlrev_b32 v10, 16, v10
    v_sub_f32 v11, v11, v16
    v_cvt_pk_bf16_f32 v11, v11, v11
    v_lshlrev_b32 v11, 16, v11
    v_mul_f32 v11, v11, v18
    v_cvt_pk_bf16_f32 v11, v11, v11
    v_lshlrev_b32 v11, 16, v11
    v_sub_f32 v12, v12, v16
    v_cvt_pk_bf16_f32 v12, v12, v12
    v_lshlrev_b32 v12, 16, v12
    v_mul_f32 v12, v12, v18
    v_cvt_pk_bf16_f32 v12, v12, v12
    v_lshlrev_b32 v12, 16, v12
    v_sub_f32 v13, v13, v16
    v_cvt_pk_bf16_f32 v13, v13, v13
    v_lshlrev_b32 v13, 16, v13
    v_mul_f32 v13, v13, v18
    v_cvt_pk_bf16_f32 v13, v13, v13
    v_lshlrev_b32 v13, 16, v13
    v_sub_f32 v14, v14, v16
    v_cvt_pk_bf16_f32 v14, v14, v14
    v_lshlrev_b32 v14, 16, v14
    v_mul_f32 v14, v14, v18
    v_cvt_pk_bf16_f32 v14, v14, v14
    v_lshlrev_b32 v14, 16, v14
    v_sub_f32 v15, v15, v16
    v_cvt_pk_bf16_f32 v15, v15, v15
    v_lshlrev_b32 v15, 16, v15
    v_mul_f32 v15, v15, v18
    v_cvt_pk_bf16_f32 v15, v15, v15
    v_lshlrev_b32 v15, 16, v15
    v_lshl_add_u32 v5, v1, 5, v81
    ds_write_b128 v5, v[8:11]
    ds_write_b128 v5, v[12:15] offset:16
    v_lshl_add_u32 v5, v0, 2, v81
    s_waitcnt lgkmcnt(0)
    ds_read_b32 v16, v5
    s_waitcnt vmcnt(0)
    v_lshlrev_b32 v20, 16, v72
    v_and_b32 v21, 0xffff0000, v72
    v_lshlrev_b32 v22, 16, v73
    v_and_b32 v23, 0xffff0000, v73
    v_lshlrev_b32 v24, 16, v74
    v_and_b32 v25, 0xffff0000, v74
    v_lshlrev_b32 v26, 16, v75
    v_and_b32 v27, 0xffff0000, v75
    s_waitcnt lgkmcnt(0)
    v_mul_f32 v20, v16, v20
    v_mul_f32 v21, v16, v21
    v_mul_f32 v22, v16, v22
    v_mul_f32 v23, v16, v23
    v_mul_f32 v24, v16, v24
    v_mul_f32 v25, v16, v25
    v_mul_f32 v26, v16, v26
    v_mul_f32 v27, v16, v27
    s_nop 1
    v_permlane32_swap_b32 v20, v24
    v_permlane32_swap_b32 v21, v25
    v_permlane32_swap_b32 v22, v26
    v_permlane32_swap_b32 v23, v27
    s_nop 1
    v_add_f32 v20, v20, v24
    v_add_f32 v21, v21, v25
    v_add_f32 v22, v22, v26
    v_add_f32 v23, v23, v27
    s_nop 1
    v_permlane16_swap_b32 v20, v22
    v_permlane16_swap_b32 v21, v23
    s_nop 1
    v_add_f32 v20, v20, v22
    v_add_f32 v21, v21, v23
    s_nop 1
    v_add_f32_dpp v20, v20, v20 row_shr:1 row_mask:0xf bank_mask:0xf bound_ctrl:0
    v_add_f32_dpp v21, v21, v21 row_shr:1 row_mask:0xf bank_mask:0xf bound_ctrl:0
    s_nop 1
    v_add_f32_dpp v20, v20, v20 row_shr:2 row_mask:0xf bank_mask:0xf bound_ctrl:0
    v_add_f32_dpp v21, v21, v21 row_shr:2 row_mask:0xf bank_mask:0xf bound_ctrl:0
    s_nop 1
    v_add_f32_dpp v20, v20, v20 row_shr:4 row_mask:0xf bank_mask:0xf bound_ctrl:0
    v_add_f32_dpp v21, v21, v21 row_shr:4 row_mask:0xf bank_mask:0xf bound_ctrl:0
    s_nop 1
    v_add_f32_dpp v20, v20, v20 row_shr:8 row_mask:0xf bank_mask:0xf bound_ctrl:0
    v_add_f32_dpp v21, v21, v21 row_shr:8 row_mask:0xf bank_mask:0xf bound_ctrl:0
    v_lshrrev_b32 v4, 5, v1
    v_lshlrev_b32 v5, 4, v4
    v_and_b32 v4, 1, v7
    v_lshl_add_u32 v5, v4, 3, v5
    v_lshl_add_u32 v5, v2, 5, v5
    v_cmp_eq_u32 vcc, 15, v6
    s_and_saveexec_b64 s[24:25], vcc
    ds_write_b64 v5, v[20:21] offset:19456
    s_mov_b64 exec, s[24:25]
    s_waitcnt lgkmcnt(0)
    s_barrier
    v_and_b32 v4, 7, v0
    v_lshlrev_b32 v5, 2, v4
    ds_read_b32 v8, v5 offset:19456
    ds_read_b32 v9, v5 offset:19488
    ds_read_b32 v10, v5 offset:19520
    ds_read_b32 v11, v5 offset:19552
    ds_read_b32 v12, v5 offset:19584
    ds_read_b32 v13, v5 offset:19616
    ds_read_b32 v14, v5 offset:19648
    ds_read_b32 v15, v5 offset:19680
    s_waitcnt lgkmcnt(0)
    v_add_f32 v8, v8, v9
    v_add_f32 v10, v10, v11
    v_add_f32 v12, v12, v13
    v_add_f32 v14, v14, v15
    v_add_f32 v8, v8, v10
    v_add_f32 v12, v12, v14
    v_add_f32 v8, v8, v12
    v_cvt_pk_bf16_f32 v8, v8, v8
    v_lshlrev_b32 v8, 16, v8
    v_lshlrev_b32 v80, 16, v80
    v_add_f32 v8, v8, v80
    v_cvt_pk_bf16_f32 v8, v8, v8
    v_lshlrev_b32 v8, 16, v8
    v_mul_f32 v9, v8, v8
    v_mul_f32 v9, v9, v8
    v_mov_b32 v10, 0x3d372713
    v_fma_f32 v9, v9, v10, v8
    v_mul_f32 v9, 0x3f4c422a, v9
    v_mul_f32 v9, 0x4038aa3b, v9
    v_exp_f32 v9, v9
    s_nop 0
    v_add_f32 v9, 1.0, v9
    v_rcp_f32 v9, v9
    s_nop 0
    v_fma_f32 v9, v9, -2.0, 2.0
    v_mul_f32 v9, v9, v8
    v_mul_f32 v9, 0.5, v9
    v_cvt_pk_bf16_f32 v9, v9, v9
    v_lshlrev_b32 v9, 16, v9
    s_nop 0
    v_readlane_b32 s24, v9, s31
    v_lshlrev_b32 v16, 16, v76
    v_and_b32 v17, 0xffff0000, v76
    v_lshlrev_b32 v18, 16, v77
    v_and_b32 v19, 0xffff0000, v77
    v_lshlrev_b32 v20, 16, v78
    v_and_b32 v21, 0xffff0000, v78
    v_lshlrev_b32 v22, 16, v79
    v_and_b32 v23, 0xffff0000, v79
    s_nop 1
    v_mul_f32 v16, s24, v16
    v_mul_f32 v17, s24, v17
    v_mul_f32 v18, s24, v18
    v_mul_f32 v19, s24, v19
    v_mul_f32 v20, s24, v20
    v_mul_f32 v21, s24, v21
    v_mul_f32 v22, s24, v22
    v_mul_f32 v23, s24, v23
    v_lshl_add_u32 v5, v1, 5, v81
    ds_write_b128 v5, v[16:19] offset:20480
    ds_write_b128 v5, v[20:23] offset:20496
    s_waitcnt lgkmcnt(0)
    s_barrier
    v_lshlrev_b32 v5, 2, v0
    ds_read_b32 v8, v5 offset:20480
    ds_read_b32 v9, v5 offset:22528
    ds_read_b32 v10, v5 offset:24576
    ds_read_b32 v11, v5 offset:26624
    ds_read_b32 v12, v5 offset:28672
    ds_read_b32 v13, v5 offset:30720
    ds_read_b32 v14, v5 offset:32768
    ds_read_b32 v15, v5 offset:34816
    s_waitcnt lgkmcnt(0)
    v_add_f32 v8, v8, v9
    v_add_f32 v10, v10, v11
    v_add_f32 v12, v12, v13
    v_add_f32 v14, v14, v15
    v_add_f32 v8, v8, v10
    v_add_f32 v12, v12, v14
    v_add_f32 v8, v8, v12
    s_lshl_b32 s24, s2, 11
    s_add_u32 s24, s24, 786432
    v_add_u32 v5, s24, v5
    buffer_store_dword v8, v5, s[20:23], 0 offen
K4_END:
    s_endpgm
.globl k1_qproj_kernel
.p2align 8
.type k1_qproj_kernel,@function
k1_qproj_kernel:
    s_cmp_ge_u32 s2, 256
    s_cbranch_scc1 K1_END
    s_load_dwordx2 s[4:5], s[0:1], 0
    s_load_dwordx2 s[6:7], s[0:1], 24
    s_load_dwordx2 s[8:9], s[0:1], 96
    v_and_b32 v1, 63, v0
    v_lshrrev_b32 v2, 6, v0
    s_waitcnt lgkmcnt(0)
    s_mov_b32 s12, s4
    s_mov_b32 s13, s5
    s_mov_b32 s14, 1024
    s_mov_b32 s15, 0x00020000
    s_mov_b32 s16, s6
    s_mov_b32 s17, s7
    s_mov_b32 s18, 4194304
    s_mov_b32 s19, 0x00020000
    s_mov_b32 s20, s8
    s_mov_b32 s21, s9
    s_mov_b32 s22, 8192
    s_mov_b32 s23, 0x00020000
    s_and_b32 s24, s2, 7
    s_lshr_b32 s25, s2, 5
    s_lshl_b32 s25, s25, 3
    s_add_u32 s24, s24, s25
    s_lshl_b32 s24, s24, 6
    s_lshr_b32 s25, s2, 3
    s_and_b32 s25, s25, 3
    s_lshl_b32 s25, s25, 4
    s_add_u32 s24, s24, s25
    s_lshl_b32 s25, s24, 1
    v_lshlrev_b32 v3, 4, v1
    buffer_load_dwordx4 v[4:7], v3, s[12:15], 0 offen
    v_lshrrev_b32 v8, 2, v1
    v_lshl_add_u32 v8, v2, 7, v8
    v_lshlrev_b32 v9, 13, v8
    v_and_b32 v10, 3, v1
    v_lshl_add_u32 v9, v10, 3, v9
    v_add_u32 v9, s25, v9
    buffer_load_dwordx2 v[32:33], v9, s[16:19], 0 offen
    v_add_u32 v9, 0x20000, v9
    buffer_load_dwordx2 v[34:35], v9, s[16:19], 0 offen
    v_add_u32 v9, 0x20000, v9
    buffer_load_dwordx2 v[36:37], v9, s[16:19], 0 offen
    v_add_u32 v9, 0x20000, v9
    buffer_load_dwordx2 v[38:39], v9, s[16:19], 0 offen
    v_add_u32 v9, 0x20000, v9
    buffer_load_dwordx2 v[40:41], v9, s[16:19], 0 offen
    v_add_u32 v9, 0x20000, v9
    buffer_load_dwordx2 v[42:43], v9, s[16:19], 0 offen
    v_add_u32 v9, 0x20000, v9
    buffer_load_dwordx2 v[44:45], v9, s[16:19], 0 offen
    v_add_u32 v9, 0x20000, v9
    buffer_load_dwordx2 v[46:47], v9, s[16:19], 0 offen
    s_waitcnt vmcnt(8)
    v_lshlrev_b32 v16, 16, v4
    v_and_b32 v17, 0xffff0000, v4
    v_lshlrev_b32 v18, 16, v5
    v_and_b32 v19, 0xffff0000, v5
    v_lshlrev_b32 v20, 16, v6
    v_and_b32 v21, 0xffff0000, v6
    v_lshlrev_b32 v22, 16, v7
    v_and_b32 v23, 0xffff0000, v7
    v_add_f32 v24, v16, v17
    v_add_f32 v24, v24, v18
    v_add_f32 v24, v24, v19
    v_add_f32 v24, v24, v20
    v_add_f32 v24, v24, v21
    v_add_f32 v24, v24, v22
    v_add_f32 v24, v24, v23
    s_nop 1
    v_add_f32_dpp v24, v24, v24 row_shr:1 row_mask:0xf bank_mask:0xf bound_ctrl:0
    s_nop 1
    v_add_f32_dpp v24, v24, v24 row_shr:2 row_mask:0xf bank_mask:0xf bound_ctrl:0
    s_nop 1
    v_add_f32_dpp v24, v24, v24 row_shr:4 row_mask:0xf bank_mask:0xf bound_ctrl:0
    s_nop 1
    v_add_f32_dpp v24, v24, v24 row_shr:8 row_mask:0xf bank_mask:0xf bound_ctrl:0
    s_nop 1
    v_add_f32_dpp v24, v24, v24 row_bcast:15 row_mask:0xa bank_mask:0xf
    s_nop 1
    v_add_f32_dpp v24, v24, v24 row_bcast:31 row_mask:0xc bank_mask:0xf
    s_nop 1
    v_readlane_b32 s26, v24, 63
    s_nop 1
    v_mov_b32 v24, s26
    v_mul_f32 v24, 0x3b000000, v24
    v_sub_f32 v25, v16, v24
    v_mul_f32 v26, v25, v25
    v_sub_f32 v25, v17, v24
    v_fmac_f32 v26, v25, v25
    v_sub_f32 v25, v18, v24
    v_fmac_f32 v26, v25, v25
    v_sub_f32 v25, v19, v24
    v_fmac_f32 v26, v25, v25
    v_sub_f32 v25, v20, v24
    v_fmac_f32 v26, v25, v25
    v_sub_f32 v25, v21, v24
    v_fmac_f32 v26, v25, v25
    v_sub_f32 v25, v22, v24
    v_fmac_f32 v26, v25, v25
    v_sub_f32 v25, v23, v24
    v_fmac_f32 v26, v25, v25
    s_nop 1
    v_add_f32_dpp v26, v26, v26 row_shr:1 row_mask:0xf bank_mask:0xf bound_ctrl:0
    s_nop 1
    v_add_f32_dpp v26, v26, v26 row_shr:2 row_mask:0xf bank_mask:0xf bound_ctrl:0
    s_nop 1
    v_add_f32_dpp v26, v26, v26 row_shr:4 row_mask:0xf bank_mask:0xf bound_ctrl:0
    s_nop 1
    v_add_f32_dpp v26, v26, v26 row_shr:8 row_mask:0xf bank_mask:0xf bound_ctrl:0
    s_nop 1
    v_add_f32_dpp v26, v26, v26 row_bcast:15 row_mask:0xa bank_mask:0xf
    s_nop 1
    v_add_f32_dpp v26, v26, v26 row_bcast:31 row_mask:0xc bank_mask:0xf
    s_nop 1
    v_readlane_b32 s27, v26, 63
    s_nop 1
    v_mov_b32 v26, s27
    v_mul_f32 v26, 0x3b000000, v26
    v_cvt_pk_bf16_f32 v26, v26, v26
    v_lshlrev_b32 v26, 16, v26
    v_add_f32 v26, 0x3727c5ac, v26
    v_cvt_pk_bf16_f32 v26, v26, v26
    v_lshlrev_b32 v26, 16, v26
    v_sqrt_f32 v26, v26
    s_nop 0
    v_cvt_pk_bf16_f32 v26, v26, v26
    v_lshlrev_b32 v26, 16, v26
    v_rcp_f32 v26, v26
    v_cvt_pk_bf16_f32 v24, v24, v24
    v_lshlrev_b32 v24, 16, v24
    v_sub_f32 v16, v16, v24
    v_cvt_pk_bf16_f32 v16, v16, v16
    v_lshlrev_b32 v16, 16, v16
    v_mul_f32 v16, v16, v26
    v_cvt_pk_bf16_f32 v16, v16, v16
    v_lshlrev_b32 v16, 16, v16
    v_sub_f32 v17, v17, v24
    v_cvt_pk_bf16_f32 v17, v17, v17
    v_lshlrev_b32 v17, 16, v17
    v_mul_f32 v17, v17, v26
    v_cvt_pk_bf16_f32 v17, v17, v17
    v_lshlrev_b32 v17, 16, v17
    v_sub_f32 v18, v18, v24
    v_cvt_pk_bf16_f32 v18, v18, v18
    v_lshlrev_b32 v18, 16, v18
    v_mul_f32 v18, v18, v26
    v_cvt_pk_bf16_f32 v18, v18, v18
    v_lshlrev_b32 v18, 16, v18
    v_sub_f32 v19, v19, v24
    v_cvt_pk_bf16_f32 v19, v19, v19
    v_lshlrev_b32 v19, 16, v19
    v_mul_f32 v19, v19, v26
    v_cvt_pk_bf16_f32 v19, v19, v19
    v_lshlrev_b32 v19, 16, v19
    v_sub_f32 v20, v20, v24
    v_cvt_pk_bf16_f32 v20, v20, v20
    v_lshlrev_b32 v20, 16, v20
    v_mul_f32 v20, v20, v26
    v_cvt_pk_bf16_f32 v20, v20, v20
    v_lshlrev_b32 v20, 16, v20
    v_sub_f32 v21, v21, v24
    v_cvt_pk_bf16_f32 v21, v21, v21
    v_lshlrev_b32 v21, 16, v21
    v_mul_f32 v21, v21, v26
    v_cvt_pk_bf16_f32 v21, v21, v21
    v_lshlrev_b32 v21, 16, v21
    v_sub_f32 v22, v22, v24
    v_cvt_pk_bf16_f32 v22, v22, v22
    v_lshlrev_b32 v22, 16, v22
    v_mul_f32 v22, v22, v26
    v_cvt_pk_bf16_f32 v22, v22, v22
    v_lshlrev_b32 v22, 16, v22
    v_sub_f32 v23, v23, v24
    v_cvt_pk_bf16_f32 v23, v23, v23
    v_lshlrev_b32 v23, 16, v23
    v_mul_f32 v23, v23, v26
    v_cvt_pk_bf16_f32 v23, v23, v23
    v_lshlrev_b32 v23, 16, v23
    v_lshlrev_b32 v11, 11, v2
    v_lshl_add_u32 v12, v1, 5, v11
    ds_write_b128 v12, v[16:19]
    ds_write_b128 v12, v[20:23] offset:16
    v_lshl_add_u32 v12, v8, 2, v11
    s_waitcnt lgkmcnt(0)
    ds_read_b32 v16, v12 offset:0
    ds_read_b32 v17, v12 offset:64
    ds_read_b32 v18, v12 offset:128
    ds_read_b32 v19, v12 offset:192
    ds_read_b32 v20, v12 offset:256
    ds_read_b32 v21, v12 offset:320
    ds_read_b32 v22, v12 offset:384
    ds_read_b32 v23, v12 offset:448
    v_mov_b32 v24, 0
    v_mov_b32 v25, 0
    v_mov_b32 v26, 0
    v_mov_b32 v27, 0
    s_waitcnt lgkmcnt(0)
    s_waitcnt vmcnt(7)
    v_lshlrev_b32 v28, 16, v32
    v_and_b32 v29, 0xffff0000, v32
    v_lshlrev_b32 v30, 16, v33
    v_and_b32 v31, 0xffff0000, v33
    v_fmac_f32 v24, v16, v28
    v_fmac_f32 v25, v16, v29
    v_fmac_f32 v26, v16, v30
    v_fmac_f32 v27, v16, v31
    s_waitcnt vmcnt(6)
    v_lshlrev_b32 v28, 16, v34
    v_and_b32 v29, 0xffff0000, v34
    v_lshlrev_b32 v30, 16, v35
    v_and_b32 v31, 0xffff0000, v35
    v_fmac_f32 v24, v17, v28
    v_fmac_f32 v25, v17, v29
    v_fmac_f32 v26, v17, v30
    v_fmac_f32 v27, v17, v31
    s_waitcnt vmcnt(5)
    v_lshlrev_b32 v28, 16, v36
    v_and_b32 v29, 0xffff0000, v36
    v_lshlrev_b32 v30, 16, v37
    v_and_b32 v31, 0xffff0000, v37
    v_fmac_f32 v24, v18, v28
    v_fmac_f32 v25, v18, v29
    v_fmac_f32 v26, v18, v30
    v_fmac_f32 v27, v18, v31
    s_waitcnt vmcnt(4)
    v_lshlrev_b32 v28, 16, v38
    v_and_b32 v29, 0xffff0000, v38
    v_lshlrev_b32 v30, 16, v39
    v_and_b32 v31, 0xffff0000, v39
    v_fmac_f32 v24, v19, v28
    v_fmac_f32 v25, v19, v29
    v_fmac_f32 v26, v19, v30
    v_fmac_f32 v27, v19, v31
    s_waitcnt vmcnt(3)
    v_lshlrev_b32 v28, 16, v40
    v_and_b32 v29, 0xffff0000, v40
    v_lshlrev_b32 v30, 16, v41
    v_and_b32 v31, 0xffff0000, v41
    v_fmac_f32 v24, v20, v28
    v_fmac_f32 v25, v20, v29
    v_fmac_f32 v26, v20, v30
    v_fmac_f32 v27, v20, v31
    s_waitcnt vmcnt(2)
    v_lshlrev_b32 v28, 16, v42
    v_and_b32 v29, 0xffff0000, v42
    v_lshlrev_b32 v30, 16, v43
    v_and_b32 v31, 0xffff0000, v43
    v_fmac_f32 v24, v21, v28
    v_fmac_f32 v25, v21, v29
    v_fmac_f32 v26, v21, v30
    v_fmac_f32 v27, v21, v31
    s_waitcnt vmcnt(1)
    v_lshlrev_b32 v28, 16, v44
    v_and_b32 v29, 0xffff0000, v44
    v_lshlrev_b32 v30, 16, v45
    v_and_b32 v31, 0xffff0000, v45
    v_fmac_f32 v24, v22, v28
    v_fmac_f32 v25, v22, v29
    v_fmac_f32 v26, v22, v30
    v_fmac_f32 v27, v22, v31
    s_waitcnt vmcnt(0)
    v_lshlrev_b32 v28, 16, v46
    v_and_b32 v29, 0xffff0000, v46
    v_lshlrev_b32 v30, 16, v47
    v_and_b32 v31, 0xffff0000, v47
    v_fmac_f32 v24, v23, v28
    v_fmac_f32 v25, v23, v29
    v_fmac_f32 v26, v23, v30
    v_fmac_f32 v27, v23, v31
    s_nop 1
    v_add_f32_dpp v24, v24, v24 row_shr:4 row_mask:0xf bank_mask:0xf bound_ctrl:0
    v_add_f32_dpp v25, v25, v25 row_shr:4 row_mask:0xf bank_mask:0xf bound_ctrl:0
    v_add_f32_dpp v26, v26, v26 row_shr:4 row_mask:0xf bank_mask:0xf bound_ctrl:0
    v_add_f32_dpp v27, v27, v27 row_shr:4 row_mask:0xf bank_mask:0xf bound_ctrl:0
    s_nop 1
    v_add_f32_dpp v24, v24, v24 row_shr:8 row_mask:0xf bank_mask:0xf bound_ctrl:0
    v_add_f32_dpp v25, v25, v25 row_shr:8 row_mask:0xf bank_mask:0xf bound_ctrl:0
    v_add_f32_dpp v26, v26, v26 row_shr:8 row_mask:0xf bank_mask:0xf bound_ctrl:0
    v_add_f32_dpp v27, v27, v27 row_shr:8 row_mask:0xf bank_mask:0xf bound_ctrl:0
    v_lshrrev_b32 v12, 4, v0
    v_lshlrev_b32 v12, 6, v12
    v_lshl_add_u32 v12, v10, 4, v12
    v_and_b32 v13, 15, v1
    v_cmp_le_u32 vcc, 12, v13
    s_and_saveexec_b64 s[28:29], vcc
    ds_write_b128 v12, v[24:27] offset:8192
    s_mov_b64 exec, s[28:29]
    s_waitcnt lgkmcnt(0)
    s_barrier
    v_cmp_gt_u32 vcc, 16, v0
    s_and_saveexec_b64 s[28:29], vcc
    s_cbranch_execz K1_END
    v_lshlrev_b32 v12, 2, v0
    ds_read_b32 v32, v12 offset:8192
    ds_read_b32 v33, v12 offset:8256
    ds_read_b32 v34, v12 offset:8320
    ds_read_b32 v35, v12 offset:8384
    ds_read_b32 v36, v12 offset:8448
    ds_read_b32 v37, v12 offset:8512
    ds_read_b32 v38, v12 offset:8576
    ds_read_b32 v39, v12 offset:8640
    ds_read_b32 v40, v12 offset:8704
    ds_read_b32 v41, v12 offset:8768
    ds_read_b32 v42, v12 offset:8832
    ds_read_b32 v43, v12 offset:8896
    ds_read_b32 v44, v12 offset:8960
    ds_read_b32 v45, v12 offset:9024
    ds_read_b32 v46, v12 offset:9088
    ds_read_b32 v47, v12 offset:9152
    s_waitcnt lgkmcnt(0)
    v_add_f32 v32, v32, v33
    v_add_f32 v32, v32, v34
    v_add_f32 v32, v32, v35
    v_add_f32 v32, v32, v36
    v_add_f32 v32, v32, v37
    v_add_f32 v32, v32, v38
    v_add_f32 v32, v32, v39
    v_add_f32 v32, v32, v40
    v_add_f32 v32, v32, v41
    v_add_f32 v32, v32, v42
    v_add_f32 v32, v32, v43
    v_add_f32 v32, v32, v44
    v_add_f32 v32, v32, v45
    v_add_f32 v32, v32, v46
    v_add_f32 v32, v32, v47
    v_cvt_pk_bf16_f32 v32, v32, v32
    v_lshlrev_b32 v12, 1, v0
    v_add_u32 v12, s25, v12
    buffer_store_short v32, v12, s[20:23], 0 offen
K1_END:
    s_endpgm
.globl k3_wo_kernel
.p2align 8
.type k3_wo_kernel,@function
k3_wo_kernel:
    s_cmp_ge_u32 s2, 256
    s_cbranch_scc1 K3_END
    s_load_dwordx2 s[4:5], s[0:1], 32
    s_load_dwordx2 s[8:9], s[0:1], 96
    v_and_b32 v1, 63, v0
    v_lshrrev_b32 v2, 6, v0
    s_lshr_b32 s24, s2, 3
    s_and_b32 s25, s2, 7
    s_waitcnt lgkmcnt(0)
    s_mov_b32 s12, s4
    s_mov_b32 s13, s5
    s_mov_b32 s14, 4194304
    s_mov_b32 s15, 0x00020000
    s_mov_b32 s20, s8
    s_mov_b32 s21, s9
    s_mov_b32 s22, 1376256
    s_mov_b32 s23, 0x00020000
    s_lshl_b32 s26, s24, 17
    s_lshl_b32 s27, s25, 7
    s_add_u32 s26, s26, s27
    v_lshrrev_b32 v3, 3, v0
    v_and_b32 v4, 7, v0
    v_lshlrev_b32 v5, 10, v3
    v_lshl_add_u32 v5, v4, 4, v5
    v_add_u32 v5, s26, v5
    buffer_load_dwordx4 v[64:67], v5, s[12:15], 0 offen offset:0
    v_add_u32 v5, 0x8000, v5
    buffer_load_dwordx4 v[68:71], v5, s[12:15], 0 offen offset:0
    v_add_u32 v5, 0x8000, v5
    buffer_load_dwordx4 v[72:75], v5, s[12:15], 0 offen offset:0
    v_add_u32 v5, 0x8000, v5
    buffer_load_dwordx4 v[76:79], v5, s[12:15], 0 offen offset:0
    s_lshr_b32 s26, s24, 2
    s_and_b32 s27, s24, 3
    s_lshl_b32 s28, s26, 10
    s_lshl_b32 s29, s27, 3
    s_add_u32 s28, s28, s29
    s_add_u32 s28, s28, 589824
    v_and_b32 v6, 31, v1
    v_lshlrev_b32 v7, 5, v6
    v_add_u32 v7, s28, v7
    buffer_load_dwordx2 v[8:9], v7, s[20:23], 0 offen
    s_lshl_b32 s28, s26, 16
    s_lshl_b32 s29, s27, 9
    s_add_u32 s28, s28, s29
    s_add_u32 s28, s28, 65536
    v_and_b32 v10, 127, v0
    v_lshrrev_b32 v11, 7, v0
    v_lshlrev_b32 v12, 15, v11
    v_lshl_add_u32 v12, v10, 2, v12
    v_add_u32 v12, s28, v12
    buffer_load_dword v32, v12, s[20:23], 0 offen offset:0
    buffer_load_dword v33, v12, s[20:23], 0 offen offset:2048
    v_add_u32 v12, 0x1000, v12
    buffer_load_dword v34, v12, s[20:23], 0 offen offset:0
    buffer_load_dword v35, v12, s[20:23], 0 offen offset:2048
    v_add_u32 v12, 0x1000, v12
    buffer_load_dword v36, v12, s[20:23], 0 offen offset:0
    buffer_load_dword v37, v12, s[20:23], 0 offen offset:2048
    v_add_u32 v12, 0x1000, v12
    buffer_load_dword v38, v12, s[20:23], 0 offen offset:0
    buffer_load_dword v39, v12, s[20:23], 0 offen offset:2048
    v_add_u32 v12, 0x1000, v12
    buffer_load_dword v40, v12, s[20:23], 0 offen offset:0
    buffer_load_dword v41, v12, s[20:23], 0 offen offset:2048
    v_add_u32 v12, 0x1000, v12
    buffer_load_dword v42, v12, s[20:23], 0 offen offset:0
    buffer_load_dword v43, v12, s[20:23], 0 offen offset:2048
    v_add_u32 v12, 0x1000, v12
    buffer_load_dword v44, v12, s[20:23], 0 offen offset:0
    buffer_load_dword v45, v12, s[20:23], 0 offen offset:2048
    v_add_u32 v12, 0x1000, v12
    buffer_load_dword v46, v12, s[20:23], 0 offen offset:0
    buffer_load_dword v47, v12, s[20:23], 0 offen offset:2048
    v_add_u32 v12, 0x1000, v12
    s_waitcnt vmcnt(16)
    v_mov_b32 v13, v8
    s_nop 1
    v_max_f32_dpp v13, v13, v13 row_shr:1 row_mask:0xf bank_mask:0xf
    s_nop 1
    v_max_f32_dpp v13, v13, v13 row_shr:2 row_mask:0xf bank_mask:0xf
    s_nop 1
    v_max_f32_dpp v13, v13, v13 row_shr:4 row_mask:0xf bank_mask:0xf
    s_nop 1
    v_max_f32_dpp v13, v13, v13 row_shr:8 row_mask:0xf bank_mask:0xf
    s_nop 1
    v_readlane_b32 s30, v13, 15
    v_readlane_b32 s31, v13, 31
    s_nop 1
    v_mov_b32 v13, s30
    v_max_f32 v13, s31, v13
    v_sub_f32 v14, v8, v13
    v_mul_f32 v14, 0x3fb8aa3b, v14
    v_exp_f32 v14, v14
    s_nop 0
    v_mul_f32 v15, v14, v9
    s_nop 1
    v_add_f32_dpp v15, v15, v15 row_shr:1 row_mask:0xf bank_mask:0xf bound_ctrl:0
    s_nop 1
    v_add_f32_dpp v15, v15, v15 row_shr:2 row_mask:0xf bank_mask:0xf bound_ctrl:0
    s_nop 1
    v_add_f32_dpp v15, v15, v15 row_shr:4 row_mask:0xf bank_mask:0xf bound_ctrl:0
    s_nop 1
    v_add_f32_dpp v15, v15, v15 row_shr:8 row_mask:0xf bank_mask:0xf bound_ctrl:0
    s_nop 1
    v_readlane_b32 s30, v15, 15
    v_readlane_b32 s31, v15, 31
    s_nop 1
    v_mov_b32 v15, s30
    v_add_f32 v15, s31, v15
    v_rcp_f32 v15, v15
    s_nop 0
    v_mul_f32 v14, v14, v15
    v_lshlrev_b32 v16, 7, v2
    v_lshl_add_u32 v17, v6, 2, v16
    ds_write_b32 v17, v14
    v_lshl_add_u32 v17, v11, 6, v16
    s_waitcnt lgkmcnt(0)
    ds_read_b128 v[48:51], v17 offset:0
    ds_read_b128 v[52:55], v17 offset:16
    ds_read_b128 v[56:59], v17 offset:32
    ds_read_b128 v[60:63], v17 offset:48
    s_waitcnt lgkmcnt(0) vmcnt(0)
    v_mul_f32 v18, v32, v48
    v_fmac_f32 v18, v33, v49
    v_fmac_f32 v18, v34, v50
    v_fmac_f32 v18, v35, v51
    v_fmac_f32 v18, v36, v52
    v_fmac_f32 v18, v37, v53
    v_fmac_f32 v18, v38, v54
    v_fmac_f32 v18, v39, v55
    v_fmac_f32 v18, v40, v56
    v_fmac_f32 v18, v41, v57
    v_fmac_f32 v18, v42, v58
    v_fmac_f32 v18, v43, v59
    v_fmac_f32 v18, v44, v60
    v_fmac_f32 v18, v45, v61
    v_fmac_f32 v18, v46, v62
    v_fmac_f32 v18, v47, v63
    v_lshlrev_b32 v17, 2, v0
    ds_write_b32 v17, v18 offset:1024
    s_waitcnt lgkmcnt(0)
    s_barrier
    v_lshlrev_b32 v17, 2, v3
    ds_read_b32 v20, v17 offset:1024
    ds_read_b32 v24, v17 offset:1536
    ds_read_b32 v21, v17 offset:1152
    ds_read_b32 v25, v17 offset:1664
    ds_read_b32 v22, v17 offset:1280
    ds_read_b32 v26, v17 offset:1792
    ds_read_b32 v23, v17 offset:1408
    ds_read_b32 v27, v17 offset:1920
    s_waitcnt lgkmcnt(0)
    v_add_f32 v20, v20, v24
    v_cvt_pk_bf16_f32 v20, v20, v20
    v_lshlrev_b32 v20, 16, v20
    v_add_f32 v21, v21, v25
    v_cvt_pk_bf16_f32 v21, v21, v21
    v_lshlrev_b32 v21, 16, v21
    v_add_f32 v22, v22, v26
    v_cvt_pk_bf16_f32 v22, v22, v22
    v_lshlrev_b32 v22, 16, v22
    v_add_f32 v23, v23, v27
    v_cvt_pk_bf16_f32 v23, v23, v23
    v_lshlrev_b32 v23, 16, v23
    v_mov_b32 v40, 0
    v_mov_b32 v41, 0
    v_mov_b32 v42, 0
    v_mov_b32 v43, 0
    v_mov_b32 v44, 0
    v_mov_b32 v45, 0
    v_mov_b32 v46, 0
    v_mov_b32 v47, 0
    v_lshlrev_b32 v28, 16, v64
    v_and_b32 v29, 0xffff0000, v64
    v_fmac_f32 v40, v20, v28
    v_fmac_f32 v41, v20, v29
    v_lshlrev_b32 v28, 16, v65
    v_and_b32 v29, 0xffff0000, v65
    v_fmac_f32 v42, v20, v28
    v_fmac_f32 v43, v20, v29
    v_lshlrev_b32 v28, 16, v66
    v_and_b32 v29, 0xffff0000, v66
    v_fmac_f32 v44, v20, v28
    v_fmac_f32 v45, v20, v29
    v_lshlrev_b32 v28, 16, v67
    v_and_b32 v29, 0xffff0000, v67
    v_fmac_f32 v46, v20, v28
    v_fmac_f32 v47, v20, v29
    v_lshlrev_b32 v28, 16, v68
    v_and_b32 v29, 0xffff0000, v68
    v_fmac_f32 v40, v21, v28
    v_fmac_f32 v41, v21, v29
    v_lshlrev_b32 v28, 16, v69
    v_and_b32 v29, 0xffff0000, v69
    v_fmac_f32 v42, v21, v28
    v_fmac_f32 v43, v21, v29
    v_lshlrev_b32 v28, 16, v70
    v_and_b32 v29, 0xffff0000, v70
    v_fmac_f32 v44, v21, v28
    v_fmac_f32 v45, v21, v29
    v_lshlrev_b32 v28, 16, v71
    v_and_b32 v29, 0xffff0000, v71
    v_fmac_f32 v46, v21, v28
    v_fmac_f32 v47, v21, v29
    v_lshlrev_b32 v28, 16, v72
    v_and_b32 v29, 0xffff0000, v72
    v_fmac_f32 v40, v22, v28
    v_fmac_f32 v41, v22, v29
    v_lshlrev_b32 v28, 16, v73
    v_and_b32 v29, 0xffff0000, v73
    v_fmac_f32 v42, v22, v28
    v_fmac_f32 v43, v22, v29
    v_lshlrev_b32 v28, 16, v74
    v_and_b32 v29, 0xffff0000, v74
    v_fmac_f32 v44, v22, v28
    v_fmac_f32 v45, v22, v29
    v_lshlrev_b32 v28, 16, v75
    v_and_b32 v29, 0xffff0000, v75
    v_fmac_f32 v46, v22, v28
    v_fmac_f32 v47, v22, v29
    v_lshlrev_b32 v28, 16, v76
    v_and_b32 v29, 0xffff0000, v76
    v_fmac_f32 v40, v23, v28
    v_fmac_f32 v41, v23, v29
    v_lshlrev_b32 v28, 16, v77
    v_and_b32 v29, 0xffff0000, v77
    v_fmac_f32 v42, v23, v28
    v_fmac_f32 v43, v23, v29
    v_lshlrev_b32 v28, 16, v78
    v_and_b32 v29, 0xffff0000, v78
    v_fmac_f32 v44, v23, v28
    v_fmac_f32 v45, v23, v29
    v_lshlrev_b32 v28, 16, v79
    v_and_b32 v29, 0xffff0000, v79
    v_fmac_f32 v46, v23, v28
    v_fmac_f32 v47, v23, v29
    s_nop 1
    v_add_f32_dpp v40, v40, v40 row_shr:8 row_mask:0xf bank_mask:0xf bound_ctrl:0
    v_add_f32_dpp v41, v41, v41 row_shr:8 row_mask:0xf bank_mask:0xf bound_ctrl:0
    v_add_f32_dpp v42, v42, v42 row_shr:8 row_mask:0xf bank_mask:0xf bound_ctrl:0
    v_add_f32_dpp v43, v43, v43 row_shr:8 row_mask:0xf bank_mask:0xf bound_ctrl:0
    v_add_f32_dpp v44, v44, v44 row_shr:8 row_mask:0xf bank_mask:0xf bound_ctrl:0
    v_add_f32_dpp v45, v45, v45 row_shr:8 row_mask:0xf bank_mask:0xf bound_ctrl:0
    v_add_f32_dpp v46, v46, v46 row_shr:8 row_mask:0xf bank_mask:0xf bound_ctrl:0
    v_add_f32_dpp v47, v47, v47 row_shr:8 row_mask:0xf bank_mask:0xf bound_ctrl:0
    v_lshrrev_b32 v17, 4, v0
    v_lshlrev_b32 v17, 8, v17
    v_lshl_add_u32 v17, v4, 5, v17
    v_and_b32 v19, 8, v0
    v_cmp_ne_u32 vcc, 0, v19
    s_and_saveexec_b64 s[30:31], vcc
    ds_write_b128 v17, v[40:43] offset:2048
    ds_write_b128 v17, v[44:47] offset:2064
    s_mov_b64 exec, s[30:31]
    s_waitcnt lgkmcnt(0)
    s_barrier
    v_cmp_gt_u32 vcc, 64, v0
    s_and_saveexec_b64 s[30:31], vcc
    s_cbranch_execz K3_END
    v_lshlrev_b32 v17, 2, v0
    ds_read_b32 v32, v17 offset:2048
    ds_read_b32 v33, v17 offset:2304
    ds_read_b32 v34, v17 offset:2560
    ds_read_b32 v35, v17 offset:2816
    ds_read_b32 v36, v17 offset:3072
    ds_read_b32 v37, v17 offset:3328
    ds_read_b32 v38, v17 offset:3584
    ds_read_b32 v39, v17 offset:3840
    ds_read_b32 v40, v17 offset:4096
    ds_read_b32 v41, v17 offset:4352
    ds_read_b32 v42, v17 offset:4608
    ds_read_b32 v43, v17 offset:4864
    ds_read_b32 v44, v17 offset:5120
    ds_read_b32 v45, v17 offset:5376
    ds_read_b32 v46, v17 offset:5632
    ds_read_b32 v47, v17 offset:5888
    s_waitcnt lgkmcnt(0)
    v_add_f32 v32, v32, v33
    v_add_f32 v32, v32, v34
    v_add_f32 v32, v32, v35
    v_add_f32 v32, v32, v36
    v_add_f32 v32, v32, v37
    v_add_f32 v32, v32, v38
    v_add_f32 v32, v32, v39
    v_add_f32 v32, v32, v40
    v_add_f32 v32, v32, v41
    v_add_f32 v32, v32, v42
    v_add_f32 v32, v32, v43
    v_add_f32 v32, v32, v44
    v_add_f32 v32, v32, v45
    v_add_f32 v32, v32, v46
    v_add_f32 v32, v32, v47
    s_lshl_b32 s26, s24, 11
    s_lshl_b32 s27, s25, 8
    s_add_u32 s26, s26, s27
    s_add_u32 s26, s26, 655360
    v_add_u32 v17, s26, v17
    buffer_store_dword v32, v17, s[20:23], 0 offen
K3_END:
    s_endpgm
.globl k5_fin_kernel
.p2align 8
.type k5_fin_kernel,@function
k5_fin_kernel:
    s_cmp_ge_u32 s2, 32
    s_cbranch_scc1 K5_END
    s_load_dwordx2 s[4:5], s[0:1], 72
    s_load_dwordx2 s[6:7], s[0:1], 80
    s_load_dwordx2 s[8:9], s[0:1], 96
    s_waitcnt lgkmcnt(0)
    s_mov_b32 s12, s4
    s_mov_b32 s13, s5
    s_mov_b32 s14, 1024
    s_mov_b32 s15, 0x00020000
    s_mov_b32 s16, s6
    s_mov_b32 s17, s7
    s_mov_b32 s18, 1024
    s_mov_b32 s19, 0x00020000
    s_mov_b32 s20, s8
    s_mov_b32 s21, s9
    s_mov_b32 s22, 1376256
    s_mov_b32 s23, 0x00020000
    v_and_b32 v1, 15, v0
    v_lshrrev_b32 v2, 4, v0
    s_lshl_b32 s24, s2, 6
    s_add_u32 s24, s24, 786432
    v_mul_u32_u24 v3, 14*2048, v2
    v_lshl_add_u32 v3, v1, 2, v3
    v_add_u32 v3, s24, v3
    buffer_load_dword v16, v3, s[20:23], 0 offen offset:0
    buffer_load_dword v17, v3, s[20:23], 0 offen offset:2048
    v_add_u32 v3, 0x1000, v3
    buffer_load_dword v18, v3, s[20:23], 0 offen offset:0
    buffer_load_dword v19, v3, s[20:23], 0 offen offset:2048
    v_add_u32 v3, 0x1000, v3
    buffer_load_dword v20, v3, s[20:23], 0 offen offset:0
    buffer_load_dword v21, v3, s[20:23], 0 offen offset:2048
    v_add_u32 v3, 0x1000, v3
    buffer_load_dword v22, v3, s[20:23], 0 offen offset:0
    buffer_load_dword v23, v3, s[20:23], 0 offen offset:2048
    v_add_u32 v3, 0x1000, v3
    buffer_load_dword v24, v3, s[20:23], 0 offen offset:0
    buffer_load_dword v25, v3, s[20:23], 0 offen offset:2048
    v_add_u32 v3, 0x1000, v3
    buffer_load_dword v26, v3, s[20:23], 0 offen offset:0
    buffer_load_dword v27, v3, s[20:23], 0 offen offset:2048
    v_add_u32 v3, 0x1000, v3
    buffer_load_dword v28, v3, s[20:23], 0 offen offset:0
    buffer_load_dword v29, v3, s[20:23], 0 offen offset:2048
    v_add_u32 v3, 0x1000, v3
    s_lshl_b32 s25, s2, 4
    v_add_u32 v4, s25, v1
    v_lshlrev_b32 v5, 1, v4
    buffer_load_ushort v32, v5, s[12:15], 0 offen
    v_lshlrev_b32 v6, 2, v4
    v_add_u32 v6, 1310720, v6
    buffer_load_dword v33, v6, s[20:23], 0 offen
    s_waitcnt vmcnt(2)
    v_add_f32 v16, v16, v17
    v_add_f32 v16, v16, v18
    v_add_f32 v16, v16, v19
    v_add_f32 v16, v16, v20
    v_add_f32 v16, v16, v21
    v_add_f32 v16, v16, v22
    v_add_f32 v16, v16, v23
    v_add_f32 v16, v16, v24
    v_add_f32 v16, v16, v25
    v_add_f32 v16, v16, v26
    v_add_f32 v16, v16, v27
    v_add_f32 v16, v16, v28
    v_add_f32 v16, v16, v29
    v_lshlrev_b32 v7, 2, v0
    ds_write_b32 v7, v16
    s_waitcnt lgkmcnt(0)
    s_barrier
    v_cmp_gt_u32 vcc, 16, v0
    s_and_saveexec_b64 s[28:29], vcc
    s_cbranch_execz K5_END
    ds_read_b32 v16, v7 offset:0
    ds_read_b32 v17, v7 offset:64
    ds_read_b32 v18, v7 offset:128
    ds_read_b32 v19, v7 offset:192
    ds_read_b32 v20, v7 offset:256
    ds_read_b32 v21, v7 offset:320
    ds_read_b32 v22, v7 offset:384
    ds_read_b32 v23, v7 offset:448
    ds_read_b32 v24, v7 offset:512
    ds_read_b32 v25, v7 offset:576
    ds_read_b32 v26, v7 offset:640
    ds_read_b32 v27, v7 offset:704
    ds_read_b32 v28, v7 offset:768
    ds_read_b32 v29, v7 offset:832
    ds_read_b32 v30, v7 offset:896
    ds_read_b32 v31, v7 offset:960
    s_waitcnt lgkmcnt(0) vmcnt(0)
    v_add_f32 v16, v16, v17
    v_add_f32 v16, v16, v18
    v_add_f32 v16, v16, v19
    v_add_f32 v16, v16, v20
    v_add_f32 v16, v16, v21
    v_add_f32 v16, v16, v22
    v_add_f32 v16, v16, v23
    v_add_f32 v16, v16, v24
    v_add_f32 v16, v16, v25
    v_add_f32 v16, v16, v26
    v_add_f32 v16, v16, v27
    v_add_f32 v16, v16, v28
    v_add_f32 v16, v16, v29
    v_add_f32 v16, v16, v30
    v_add_f32 v16, v16, v31
    v_cvt_pk_bf16_f32 v16, v16, v16
    v_lshlrev_b32 v16, 16, v16
    v_lshlrev_b32 v32, 16, v32
    v_add_f32 v16, v16, v32
    v_cvt_pk_bf16_f32 v16, v16, v16
    v_lshlrev_b32 v16, 16, v16
    v_add_f32 v16, v16, v33
    v_cvt_pk_bf16_f32 v16, v16, v16
    buffer_store_short v16, v5, s[16:19], 0 offen
K5_END:
    s_endpgm
.section .rodata,"a"
.p2align 6
.amdhsa_kernel k1_qproj_kernel
  .amdhsa_next_free_vgpr 96
  .amdhsa_next_free_sgpr 100
  .amdhsa_accum_offset 96
  .amdhsa_group_segment_fixed_size 0
  .amdhsa_kernarg_size 104
  .amdhsa_user_sgpr_count 2
  .amdhsa_user_sgpr_kernarg_segment_ptr 1
  .amdhsa_system_sgpr_workgroup_id_x 1
  .amdhsa_float_denorm_mode_32 3
.end_amdhsa_kernel
.p2align 6
.amdhsa_kernel k2_kernel
  .amdhsa_next_free_vgpr 120
  .amdhsa_next_free_sgpr 100
  .amdhsa_accum_offset 120
  .amdhsa_group_segment_fixed_size 0
  .amdhsa_kernarg_size 104
  .amdhsa_user_sgpr_count 2
  .amdhsa_user_sgpr_kernarg_segment_ptr 1
  .amdhsa_system_sgpr_workgroup_id_x 1
  .amdhsa_float_denorm_mode_32 3
.end_amdhsa_kernel
.p2align 6
.amdhsa_kernel k3_wo_kernel
  .amdhsa_next_free_vgpr 96
  .amdhsa_next_free_sgpr 100
  .amdhsa_accum_offset 96
  .amdhsa_group_segment_fixed_size 0
  .amdhsa_kernarg_size 104
  .amdhsa_user_sgpr_count 2
  .amdhsa_user_sgpr_kernarg_segment_ptr 1
  .amdhsa_system_sgpr_workgroup_id_x 1
  .amdhsa_float_denorm_mode_32 3
.end_amdhsa_kernel
.p2align 6
.amdhsa_kernel k4_kernel
  .amdhsa_next_free_vgpr 96
  .amdhsa_next_free_sgpr 100
  .amdhsa_accum_offset 96
  .amdhsa_group_segment_fixed_size 0
  .amdhsa_kernarg_size 104
  .amdhsa_user_sgpr_count 2
  .amdhsa_user_sgpr_kernarg_segment_ptr 1
  .amdhsa_system_sgpr_workgroup_id_x 1
  .amdhsa_float_denorm_mode_32 3
.end_amdhsa_kernel
.p2align 6
.amdhsa_kernel k5_fin_kernel
  .amdhsa_next_free_vgpr 64
  .amdhsa_next_free_sgpr 100
  .amdhsa_accum_offset 64
  .amdhsa_group_segment_fixed_size 0
  .amdhsa_kernarg_size 104
  .amdhsa_user_sgpr_count 2
  .amdhsa_user_sgpr_kernarg_segment_ptr 1
  .amdhsa_system_sgpr_workgroup_id_x 1
  .amdhsa_float_denorm_mode_32 3
.end_amdhsa_kernel
```
